```python
import torch

def _softmax(x, axis=-1):
    return torch.softmax(x, dim=axis)
def _gelu(x):
    return torch.nn.functional.gelu(x, approximate="tanh")
def _silu(x):
    return torch.nn.functional.silu(x)
def _sigmoid(x):
    return torch.sigmoid(x)
def _layernorm(x, axis=-1, eps=1e-5):
    m = x.mean(dim=axis, keepdim=True)
    v = x.var(dim=axis, keepdim=True, unbiased=False)
    return (x - m) / torch.sqrt(v + eps)
def _scatter_add(tgt, idx, src, axis=0):
    return tgt.clone().index_add_(axis, idx, src)
def _segment_sum(src, seg, n):
    out = torch.zeros((n,) + src.shape[1:], dtype=src.dtype)
    return out.index_add_(0, seg, src)
def _pad(x, pw):
    flat = tuple(v for pair in reversed(pw) for v in pair)
    return torch.nn.functional.pad(x, flat)

kernel_name = 'parallel_sum__sliding_block_cached__dense_activation_squared_relu__decode'

def setup_inputs():

    _w = (lambda a: (lambda t: t.to(torch.bfloat16) if t.is_floating_point() else t)(torch.as_tensor(a)))
    def _A_setup():
        B, Sq, D = 1, 1, 576
        Hq, Hkv, Sk, Dh = 32, 16, 65536, 128
        assert Hq % Hkv == 0, (Hq, Hkv)
        return {
            "x": _w((lambda *s: torch.randn(*s, dtype=torch.bfloat16) * 0.05)(B, Sq, D)),
            "k_cache": _w((lambda *s: torch.randn(*s, dtype=torch.bfloat16) * 3.2)(B, Hkv, Sk, Dh)),
            "v_cache": _w((lambda *s: torch.randn(*s, dtype=torch.bfloat16) * 3.2)(B, Hkv, Sk, Dh)),
            "wq": _w((lambda *s: torch.randn(*s, dtype=torch.bfloat16) * 3.2)(D, Hq * Dh) * (D ** -0.5)),
            "wo": _w((lambda *s: torch.randn(*s, dtype=torch.bfloat16) * 3.2)(Hq * Dh, D) * ((Hq * Dh) ** -0.5)),
        }
    _A_in = _A_setup()

    def _B_setup():
        B, S, D, F = 1, 1, 576, 4608
        return {
            "x": _w((lambda *s: torch.randn(*s, dtype=torch.bfloat16) * 0.05)(B, S, D)),
            "w1": _w((lambda *s: torch.randn(*s, dtype=torch.bfloat16) * 0.05)(D, F)),
            "b1": _w((lambda *s: torch.randn(*s, dtype=torch.bfloat16) * 0.8)(F)),
            "w2": _w((lambda *s: torch.randn(*s, dtype=torch.bfloat16) * 0.05)(F, D)),
            "b2": _w((lambda *s: torch.randn(*s, dtype=torch.bfloat16) * 3.2)(D)),
        }
    _B_in = _B_setup()

    return {
        "A_x": _A_in["x"],
        "A_k_cache": _A_in["k_cache"],
        "A_v_cache": _A_in["v_cache"],
        "A_wq": _A_in["wq"],
        "A_wo": _A_in["wo"],
        "B_x": _B_in["x"],
        "B_w1": _B_in["w1"],
        "B_b1": _B_in["b1"],
        "B_w2": _B_in["w2"],
        "B_b2": _B_in["b2"],
    }

def reference(A_x, A_k_cache, A_v_cache, A_wq, A_wo, B_x, B_w1, B_b1, B_w2, B_b2):
    def _A_ref(x, k_cache, v_cache, wq, wo):
        B, Sq, D = x.shape
        Hq, Dh = 32, 128
        Hkv, Sk = k_cache.shape[1], k_cache.shape[2]
        W = min(4096, max(256, Sk // 4))
        rep = Hq // Hkv
        q = (lambda x, *d: x.permute(*d))((x @ wq).reshape(B, Sq, Hq, Dh), 0, 2, 1, 3)
        k = (lambda x, n, axis: torch.repeat_interleave(x, n, dim=axis))(k_cache[:, :, Sk - W:, :], rep, axis=1)
        v = (lambda x, n, axis: torch.repeat_interleave(x, n, dim=axis))(v_cache[:, :, Sk - W:, :], rep, axis=1)
        scores = torch.einsum("bhqd,bhkd->bhqk", q, k) * (Dh ** -0.5)
        p = _softmax(scores, axis=-1)
        o = torch.einsum("bhqk,bhkd->bhqd", p, v)
        return (lambda x, *d: x.permute(*d))(o, 0, 2, 1, 3).reshape(B, Sq, Hq * Dh) @ wo

    def _B_ref(x, w1, b1, w2, b2):
        h = torch.einsum("bsd,df->bsf", x, w1) + b1
        zero = torch.zeros_like(h)
        r = torch.where(h > zero, h, zero)
        h = r * r
        out = torch.einsum("bsf,fd->bsd", h, w2) + b2
        return out

    x = A_x
    xn = _layernorm(x, axis=-1)
    return x + _A_ref(xn, A_k_cache, A_v_cache, A_wq, A_wo) + _B_ref(xn, B_w1, B_b1, B_w2, B_b2)
```

```asm
; @launch grid=(256,1,1) block=(896,1,1) lds=124928
.amdgcn_target "amdgcn-amd-amdhsa--gfx950"
.text

.globl parallel_sum__sliding_block_cached__dense_activation_squared_relu__decode_kernel
.p2align 8
.type parallel_sum__sliding_block_cached__dense_activation_squared_relu__decode_kernel,@function
parallel_sum__sliding_block_cached__dense_activation_squared_relu__decode_kernel:

s_cmp_ge_u32 s2, 256
s_cbranch_scc1 L_end
s_load_dwordx16 s[4:19], s[0:1], 0
s_load_dwordx8 s[20:27], s[0:1], 64
s_load_dwordx2 s[28:29], s[0:1], 96
v_lshrrev_b32 v1, 6, v0
v_and_b32 v0, 63, v0
s_nop 0
v_readfirstlane_b32 s30, v1
s_and_b32 s31, s2, 15
s_lshr_b32 s32, s2, 4
v_mov_b32 v1, 0
s_and_b32 s33, s32, 3
s_lshr_b32 s64, s32, 2
s_cmp_eq_u32 s30, 0
s_cbranch_scc1 L_c1
s_cmp_eq_u32 s30, 1
s_cbranch_scc1 L_c2
s_cmp_ge_u32 s30, 10
s_cbranch_scc1 L_x
s_sub_u32 s30, s30, 2
v_lshrrev_b32 v19, 3, v0
v_and_b32 v18, 7, v0
v_lshlrev_b32 v18, 4, v18
v_lshl_add_u32 v3, v19, 13, v18
s_mul_i32 s65, s64, 1179648
s_lshl_b32 s70, s31, 9
s_add_u32 s65, s65, s70
s_lshl_b32 s70, s33, 7
s_add_u32 s65, s65, s70
s_lshl_b32 s70, s30, 17
s_add_u32 s65, s65, s70
s_lshl_b32 s66, s30, 11
s_add_u32 s66, s66, 16384
v_lshlrev_b32 v2, 4, v0
s_waitcnt lgkmcnt(0)
s_mov_b32 s44, s10
s_and_b32 s45, s11, 0xffff
s_mov_b32 s46, 4718592
s_mov_b32 s47, 0x20000
s_mov_b32 m0, s66
s_nop 0
buffer_load_dwordx4 v3, s[44:47], s65 offen nt lds
s_add_u32 s70, s65, 65536
s_add_u32 s66, s66, 1024
s_mov_b32 m0, s66
s_nop 0
buffer_load_dwordx4 v3, s[44:47], s70 offen nt lds
s_load_dwordx2 s[34:35], s[28:29], 0
v_lshrrev_b32 v19, 3, v0
v_mul_u32_u24 v4, 9216, v19
v_and_b32 v18, 7, v0
v_lshl_add_u32 v4, v18, 4, v4
s_mul_hi_u32 s66, s2, 59652324
s_mul_i32 s70, s66, 72
s_sub_u32 s70, s2, s70
s_min_u32 s66, s66, 2
s_lshl_b32 s70, s70, 7
s_mul_i32 s71, s66, 1769472
s_add_u32 s67, s70, s71
s_mul_i32 s70, s30, 221184
s_add_u32 s67, s67, s70
s_mov_b32 s48, s16
s_and_b32 s49, s17, 0xffff
s_mov_b32 s50, 0
s_mov_b32 s51, 0x20000
s_cmp_lt_u32 s2, 216
s_cselect_b32 s50, 5308416, 0
s_mul_i32 s66, s30, 3072
s_add_u32 s66, s66, 34816
s_mov_b32 s36, s6
s_and_b32 s37, s7, 0xffff
s_mov_b32 s38, 268435456
s_mov_b32 s39, 0x20000
s_mov_b32 s40, s8
s_and_b32 s41, s9, 0xffff
s_mov_b32 s42, 268435456
s_mov_b32 s43, 0x20000
s_lshl_b32 s68, s31, 24
s_lshl_b32 s70, s32, 16
s_add_u32 s68, s68, s70
s_add_u32 s68, s68, 15728640
s_mul_i32 s69, s31, 4
s_mul_i32 s70, s32, 28
s_add_u32 s69, s69, s70
s_add_u32 s69, s69, s30
s_lshl_b32 s69, s69, 10
s_lshl_b32 s78, s30, 10
s_add_u32 s78, s78, 59392
s_and_b32 s70, s30, 3
s_lshl_b32 s70, s70, 2
v_lshrrev_b32 v19, 4, v0
v_and_b32 v18, 15, v0
v_add_u32 v17, s70, v19
v_xor_b32 v17, v17, v18
v_lshlrev_b32 v17, 4, v17
v_lshl_add_u32 v6, v19, 8, v17
s_barrier
s_add_u32 s70, s67, 0
s_add_u32 s71, s66, 0
s_mov_b32 m0, s71
s_nop 0
buffer_load_dwordx4 v4, s[48:51], s70 offen nt lds
s_add_u32 s70, s67, 73728
s_add_u32 s71, s66, 1024
s_mov_b32 m0, s71
s_nop 0
buffer_load_dwordx4 v4, s[48:51], s70 offen nt lds
v_lshrrev_b32 v19, 3, v0
v_and_b32 v18, 7, v0
v_lshlrev_b32 v18, 4, v18
v_mul_u32_u24 v5, 1152, v19
v_add_u32 v5, v5, v18
s_mov_b32 s52, s20
s_and_b32 s53, s21, 0xffff
s_mov_b32 s54, 0
s_mov_b32 s55, 0x20000
s_mov_b32 s56, s20
s_and_b32 s57, s21, 0xffff
s_mov_b32 s58, 0
s_mov_b32 s59, 0x20000
s_mov_b32 s60, s12
s_and_b32 s61, s13, 0xffff
s_mov_b32 s62, 4718592
s_mov_b32 s63, 0x20000
s_cmp_lt_u32 s2, 252
s_cselect_b32 s54, 5308416, 0
s_cmp_ge_u32 s2, 216
s_cselect_b32 s58, s54, 0
s_lshl_b32 s72, s2, 4
s_lshl_b32 s70, s2, 5
s_sub_u32 s70, s70, 3456
s_cmp_lt_u32 s2, 216
s_cselect_b32 s72, s72, s70
s_mul_i32 s72, s72, 1152
s_lshl_b32 s70, s30, 7
s_add_u32 s72, s72, s70
s_lshl_b32 s73, s31, 4
s_add_u32 s73, s73, s32
s_mul_i32 s73, s73, 18432
s_add_u32 s73, s73, s70
s_and_b32 s71, s2, 7
s_lshl_b32 s71, s71, 5
s_lshr_b32 s70, s2, 3
s_add_u32 s71, s71, s70
s_lshl_b32 s71, s71, 6
s_lshl_b32 s70, s30, 17
s_add_u32 s70, s70, s71
s_add_u32 s70, s70, 1048576
s_add_u32 s74, s28, s70
s_addc_u32 s75, s29, 0
v_and_b32 v19, 7, v0
v_lshlrev_b32 v14, 14, v19
v_lshrrev_b32 v18, 4, v0
v_lshl_add_u32 v14, v18, 4, v14
v_and_b32 v19, 15, v0
v_bfe_u32 v18, v19, 1, 1
v_lshlrev_b32 v18, 4, v18
v_mov_b32 v17, 0xffff
v_lshlrev_b32 v17, v18, v17
v_lshrrev_b32 v19, 2, v19
v_cmp_eq_u32 vcc, 0, v19
s_nop 1
v_cndmask_b32 v10, 0, v17, vcc
v_cmp_eq_u32 vcc, 1, v19
s_nop 1
v_cndmask_b32 v11, 0, v17, vcc
v_cmp_eq_u32 vcc, 2, v19
s_nop 1
v_cndmask_b32 v12, 0, v17, vcc
v_cmp_eq_u32 vcc, 3, v19
s_nop 1
v_cndmask_b32 v13, 0, v17, vcc
v_lshrrev_b32 v18, 4, v0
v_and_b32 v17, 1, v0
v_lshl_add_u32 v15, v18, 1, v17
v_lshlrev_b32 v15, 2, v15
v_and_b32 v17, 1, v0
v_lshlrev_b32 v17, 4, v17
v_mov_b32 v18, 0xffff
v_lshlrev_b32 v18, v17, v18
v_bfe_u32 v17, v0, 1, 2
v_cmp_eq_u32 vcc, 0, v17
s_nop 1
v_cndmask_b32 v116, 0, v18, vcc
v_cmp_eq_u32 vcc, 1, v17
s_nop 1
v_cndmask_b32 v117, 0, v18, vcc
v_cmp_eq_u32 vcc, 2, v17
s_nop 1
v_cndmask_b32 v118, 0, v18, vcc
v_cmp_eq_u32 vcc, 3, v17
s_nop 1
v_cndmask_b32 v119, 0, v18, vcc
v_bfe_u32 v17, v0, 3, 1
v_lshlrev_b32 v17, 10, v17
v_lshrrev_b32 v18, 4, v0
v_lshl_add_u32 v16, v18, 2, v17
s_lshl_b32 s70, s30, 4
s_add_u32 s70, s70, 5632
v_add_u32 v16, s70, v16
s_waitcnt vmcnt(3)
s_add_u32 s70, s67, 147456
s_add_u32 s71, s66, 2048
s_mov_b32 m0, s71
s_nop 0
buffer_load_dwordx4 v4, s[48:51], s70 offen nt lds
s_waitcnt vmcnt(3)
s_mov_b64 exec, 1
v_mov_b32 v9, 1
ds_add_u32 v1, v9 offset:3284
s_mov_b64 exec, -1
s_add_u32 s70, s69, 0
s_and_b32 s70, s70, 0xffff
s_add_u32 s70, s70, s68
s_add_u32 s71, s78, 0
s_mov_b32 m0, s71
s_nop 0
buffer_load_dwordx4 v6, s[36:39], s70 offen nt lds
s_waitcnt vmcnt(3)
s_add_u32 s70, s69, 8192
s_and_b32 s70, s70, 0xffff
s_add_u32 s70, s70, s68
s_add_u32 s71, s78, 8192
s_mov_b32 m0, s71
s_nop 0
buffer_load_dwordx4 v6, s[36:39], s70 offen nt lds
s_waitcnt vmcnt(3)
s_add_u32 s70, s69, 16384
s_and_b32 s70, s70, 0xffff
s_add_u32 s70, s70, s68
s_add_u32 s71, s78, 16384
s_mov_b32 m0, s71
s_nop 0
buffer_load_dwordx4 v6, s[36:39], s70 offen nt lds
s_waitcnt vmcnt(3)
s_mov_b64 exec, 1
v_mov_b32 v9, 1
ds_add_u32 v1, v9 offset:3288
s_mov_b64 exec, -1
s_add_u32 s70, s69, 24576
s_and_b32 s70, s70, 0xffff
s_add_u32 s70, s70, s68
s_add_u32 s71, s78, 24576
s_mov_b32 m0, s71
s_nop 0
buffer_load_dwordx4 v6, s[36:39], s70 offen nt lds
s_waitcnt vmcnt(3)
s_add_u32 s70, s69, 32768
s_and_b32 s70, s70, 0xffff
s_add_u32 s70, s70, s68
s_add_u32 s71, s78, 32768
s_mov_b32 m0, s71
s_nop 0
buffer_load_dwordx4 v6, s[36:39], s70 offen nt lds
s_waitcnt vmcnt(3)
s_add_u32 s70, s69, 40960
s_and_b32 s70, s70, 0xffff
s_add_u32 s70, s70, s68
s_add_u32 s71, s78, 40960
s_mov_b32 m0, s71
s_nop 0
buffer_load_dwordx4 v6, s[36:39], s70 offen nt lds
s_waitcnt vmcnt(3)
s_add_u32 s70, s69, 49152
s_and_b32 s70, s70, 0xffff
s_add_u32 s70, s70, s68
s_add_u32 s71, s78, 49152
s_mov_b32 m0, s71
s_nop 0
buffer_load_dwordx4 v6, s[36:39], s70 offen nt lds
s_waitcnt vmcnt(3)
s_add_u32 s70, s69, 57344
s_and_b32 s70, s70, 0xffff
s_add_u32 s70, s70, s68
s_add_u32 s71, s78, 57344
s_mov_b32 m0, s71
s_nop 0
buffer_load_dwordx4 v6, s[36:39], s70 offen nt lds
s_waitcnt vmcnt(3)
s_cmp_lg_u32 s30, 0
s_cbranch_scc1 L_prog_1
s_mov_b64 exec, 1
v_mov_b32 v9, 9
ds_write_b32 v1, v9 offset:3332
s_mov_b64 exec, -1
L_prog_1:
s_add_u32 s70, s69, 0
s_and_b32 s70, s70, 0xffff
s_add_u32 s70, s70, s68
buffer_load_dwordx4 v[44:47], v2, s[40:43], s70 offen nt
s_waitcnt vmcnt(3)
s_add_u32 s70, s69, 8192
s_and_b32 s70, s70, 0xffff
s_add_u32 s70, s70, s68
buffer_load_dwordx4 v[48:51], v2, s[40:43], s70 offen nt
s_waitcnt vmcnt(3)
s_add_u32 s70, s69, 16384
s_and_b32 s70, s70, 0xffff
s_add_u32 s70, s70, s68
buffer_load_dwordx4 v[52:55], v2, s[40:43], s70 offen nt
s_waitcnt vmcnt(3)
s_cmp_lg_u32 s30, 0
s_cbranch_scc1 L_prog_2
s_mov_b64 exec, 1
v_mov_b32 v9, 12
ds_write_b32 v1, v9 offset:3332
s_mov_b64 exec, -1
L_prog_2:
s_mov_b64 exec, 1
v_mov_b32 v9, 1
ds_add_u32 v1, v9 offset:3292
s_mov_b64 exec, -1
s_add_u32 s70, s69, 24576
s_and_b32 s70, s70, 0xffff
s_add_u32 s70, s70, s68
buffer_load_dwordx4 v[56:59], v2, s[40:43], s70 offen nt
s_waitcnt vmcnt(3)
s_add_u32 s70, s69, 32768
s_and_b32 s70, s70, 0xffff
s_add_u32 s70, s70, s68
buffer_load_dwordx4 v[60:63], v2, s[40:43], s70 offen nt
s_waitcnt vmcnt(3)
s_cmp_lg_u32 s30, 0
s_cbranch_scc1 L_prog_3
s_mov_b64 exec, 1
v_mov_b32 v9, 14
ds_write_b32 v1, v9 offset:3332
s_mov_b64 exec, -1
L_prog_3:
s_add_u32 s70, s69, 40960
s_and_b32 s70, s70, 0xffff
s_add_u32 s70, s70, s68
buffer_load_dwordx4 v[64:67], v2, s[40:43], s70 offen nt
s_waitcnt vmcnt(3)
s_add_u32 s70, s69, 49152
s_and_b32 s70, s70, 0xffff
s_add_u32 s70, s70, s68
buffer_load_dwordx4 v[68:71], v2, s[40:43], s70 offen nt
s_waitcnt vmcnt(3)
s_add_u32 s70, s69, 57344
s_and_b32 s70, s70, 0xffff
s_add_u32 s70, s70, s68
buffer_load_dwordx4 v[72:75], v2, s[40:43], s70 offen nt
s_waitcnt vmcnt(3)
s_cmp_lg_u32 s30, 0
s_cbranch_scc1 L_prog_4
s_mov_b64 exec, 1
v_mov_b32 v9, 17
ds_write_b32 v1, v9 offset:3332
s_mov_b64 exec, -1
L_prog_4:
s_add_u32 s70, s72, 0
buffer_load_dwordx4 v[20:23], v5, s[52:55], s70 offen nt
s_waitcnt vmcnt(3)
s_add_u32 s70, s72, 9216
buffer_load_dwordx4 v[24:27], v5, s[52:55], s70 offen nt
s_mov_b32 s81, 0
L_spin_5:
ds_read_b32 v9, v1 offset:3336
s_waitcnt lgkmcnt(0)
v_readfirstlane_b32 s80, v9
s_cmp_ge_u32 s80, 4
s_cbranch_scc1 L_spun_6
s_add_u32 s81, s81, 1
s_cmp_lt_u32 s81, 1048576
s_cbranch_scc1 L_spin_5
s_endpgm
L_spun_6:
s_add_u32 s34, s34, 1
s_addc_u32 s35, s35, 0
ds_read_b32 v108, v16 offset:0
ds_read_b32 v109, v16 offset:128
ds_read_b32 v110, v16 offset:256
ds_read_b32 v111, v16 offset:384
ds_read_b32 v112, v16 offset:512
ds_read_b32 v113, v16 offset:640
ds_read_b32 v114, v16 offset:768
ds_read_b32 v115, v16 offset:896
s_waitcnt lgkmcnt(0)
v_and_b32 v76, v116, v108
v_and_b32 v77, v117, v108
v_and_b32 v78, v118, v108
v_and_b32 v79, v119, v108
v_and_b32 v80, v116, v109
v_and_b32 v81, v117, v109
v_and_b32 v82, v118, v109
v_and_b32 v83, v119, v109
v_and_b32 v84, v116, v110
v_and_b32 v85, v117, v110
v_and_b32 v86, v118, v110
v_and_b32 v87, v119, v110
v_and_b32 v88, v116, v111
v_and_b32 v89, v117, v111
v_and_b32 v90, v118, v111
v_and_b32 v91, v119, v111
v_and_b32 v92, v116, v112
v_and_b32 v93, v117, v112
v_and_b32 v94, v118, v112
v_and_b32 v95, v119, v112
v_and_b32 v96, v116, v113
v_and_b32 v97, v117, v113
v_and_b32 v98, v118, v113
v_and_b32 v99, v119, v113
v_and_b32 v100, v116, v114
v_and_b32 v101, v117, v114
v_and_b32 v102, v118, v114
v_and_b32 v103, v119, v114
v_and_b32 v104, v116, v115
v_and_b32 v105, v117, v115
v_and_b32 v106, v118, v115
v_and_b32 v107, v119, v115
s_nop 1
v_mfma_f32_16x16x32_bf16 v[120:123], v[76:79], v[44:47], 0
v_mfma_f32_16x16x32_bf16 v[120:123], v[80:83], v[48:51], v[120:123]
v_mfma_f32_16x16x32_bf16 v[120:123], v[84:87], v[52:55], v[120:123]
v_mfma_f32_16x16x32_bf16 v[120:123], v[88:91], v[56:59], v[120:123]
v_mfma_f32_16x16x32_bf16 v[120:123], v[92:95], v[60:63], v[120:123]
v_mfma_f32_16x16x32_bf16 v[120:123], v[96:99], v[64:67], v[120:123]
s_waitcnt vmcnt(3)
s_add_u32 s70, s73, 0
buffer_load_dwordx4 v[28:31], v5, s[60:63], s70 offen nt
v_mfma_f32_16x16x32_bf16 v[120:123], v[100:103], v[68:71], v[120:123]
s_waitcnt vmcnt(3)
v_mfma_f32_16x16x32_bf16 v[120:123], v[104:107], v[72:75], v[120:123]
s_lshl_b32 s70, s30, 10
v_lshl_add_u32 v17, v0, 4, s70
s_nop 5
ds_write_b128 v17, v[120:123] offset:8192
s_mov_b64 exec, 1
v_mov_b32 v9, 1
ds_add_u32 v1, v9 offset:3316
s_mov_b64 exec, -1
s_add_u32 s70, s73, 9216
buffer_load_dwordx4 v[32:35], v5, s[60:63], s70 offen nt
L_term:
s_cmp_lt_u32 s2, 216
s_cbranch_scc1 L_term_a
s_cmp_ge_u32 s2, 252
s_cbranch_scc1 L_term_a
s_add_u32 s70, s72, 18432
buffer_load_dwordx4 v[36:39], v5, s[56:59], s70 offen nt
s_add_u32 s70, s72, 27648
buffer_load_dwordx4 v[40:43], v5, s[56:59], s70 offen nt
s_branch L_term_b
L_term_a:
v_mov_b32 v36, 0
v_mov_b32 v37, 0
v_mov_b32 v38, 0
v_mov_b32 v39, 0
v_mov_b32 v40, 0
v_mov_b32 v41, 0
v_mov_b32 v42, 0
v_mov_b32 v43, 0
L_term_b:
s_mov_b32 s81, 0
L_spin_7:
ds_read_b32 v9, v1 offset:3320
s_waitcnt lgkmcnt(0)
v_readfirstlane_b32 s80, v9
s_cmp_ge_u32 s80, 1
s_cbranch_scc1 L_spun_8
s_add_u32 s81, s81, 1
s_cmp_lt_u32 s81, 1048576
s_cbranch_scc1 L_spin_7
s_endpgm
L_spun_8:
ds_read_b32 v112, v15 offset:3072
ds_read_b32 v113, v15 offset:3104
ds_read_b32 v114, v15 offset:3136
ds_read_b32 v115, v15 offset:3168
s_waitcnt lgkmcnt(0)
v_and_b32 v76, v10, v112
v_and_b32 v77, v11, v112
v_and_b32 v78, v12, v112
v_and_b32 v79, v13, v112
v_and_b32 v80, v10, v113
v_and_b32 v81, v11, v113
v_and_b32 v82, v12, v113
v_and_b32 v83, v13, v113
v_and_b32 v84, v10, v114
v_and_b32 v85, v11, v114
v_and_b32 v86, v12, v114
v_and_b32 v87, v13, v114
v_and_b32 v88, v10, v115
v_and_b32 v89, v11, v115
v_and_b32 v90, v12, v115
v_and_b32 v91, v13, v115
s_waitcnt vmcnt(0)
s_mov_b64 exec, 1
v_mov_b32 v9, 1
ds_add_u32 v1, v9 offset:3340
s_mov_b64 exec, -1
v_mfma_f32_16x16x32_bf16 v[124:127], v[76:79], v[20:23], 0
v_mfma_f32_16x16x32_bf16 v[124:127], v[80:83], v[24:27], v[124:127]
v_mfma_f32_16x16x32_bf16 v[124:127], v[84:87], v[36:39], v[124:127]
v_mfma_f32_16x16x32_bf16 v[124:127], v[88:91], v[40:43], v[124:127]
v_mov_b32 v110, s34
v_mov_b32 v111, s35
s_mov_b32 s81, 0
L_spinw_9:
ds_read_b32 v9, v1 offset:3324
ds_read_b32 v112, v15 offset:3200
ds_read_b32 v113, v15 offset:3232
s_waitcnt lgkmcnt(0)
v_readfirstlane_b32 s80, v9
s_cmp_ge_u32 s80, 1
s_cbranch_scc1 L_spunw_10
s_add_u32 s81, s81, 1
s_cmp_lt_u32 s81, 1048576
s_cbranch_scc1 L_spinw_9
s_endpgm
L_spunw_10:
v_and_b32 v92, v10, v112
v_and_b32 v93, v11, v112
v_and_b32 v94, v12, v112
v_and_b32 v95, v13, v112
v_and_b32 v96, v10, v113
v_and_b32 v97, v11, v113
v_and_b32 v98, v12, v113
v_and_b32 v99, v13, v113
s_nop 1
v_mfma_f32_16x16x32_bf16 v[124:127], v[92:95], v[28:31], v[124:127]
v_mfma_f32_16x16x32_bf16 v[124:127], v[96:99], v[32:35], v[124:127]
s_nop 7
v_add_f32_dpp v108, v125, v124 row_ror:8 row_mask:0xf bank_mask:0xf
v_add_f32_dpp v109, v127, v126 row_ror:8 row_mask:0xf bank_mask:0xf
s_mov_b32 exec_lo, 0x00ff00ff
s_mov_b32 exec_hi, 0x00ff00ff
global_store_dwordx4 v14, v[108:111], s[74:75] sc1
s_cmp_ge_u32 s2, 72
s_cbranch_scc1 L_term_end
s_cmp_ge_u32 s30, 8
s_cbranch_scc1 L_term_end
s_mov_b64 exec, -1
s_lshl_b32 s70, s2, 14
s_lshl_b32 s71, s30, 11
s_add_u32 s70, s70, s71
s_add_u32 s70, s70, 1048576
s_add_u32 s74, s28, s70
s_addc_u32 s75, s29, 0
v_and_b32 v17, 3, v0
v_lshlrev_b32 v17, 6, v17
s_lshl_b32 s71, s30, 3
v_add_u32 v17, s71, v17
s_waitcnt vmcnt(0)
s_mov_b32 s81, 0
L_x3_11:
global_load_dwordx4 v[20:23], v2, s[74:75] sc1
global_load_dwordx4 v[24:27], v2, s[74:75] offset:1024 sc1
s_waitcnt vmcnt(0)
v_cmp_ne_u64 s[76:77], s[34:35], v[22:23]
v_cmp_ne_u64 vcc, s[34:35], v[26:27]
s_or_b64 s[76:77], s[76:77], vcc
s_cmp_eq_u64 s[76:77], 0
s_cbranch_scc1 L_gok_12
s_add_u32 s81, s81, 1
s_cmp_lt_u32 s81, 65536
s_cbranch_scc1 L_x3_11
s_endpgm
L_gok_12:
v_add_f32 v36, v20, v24
v_add_f32 v37, v21, v25
s_nop 0
s_nop 0
v_add_f32_dpp v36, v36, v36 row_ror:4 row_mask:0xf bank_mask:0xf
v_add_f32_dpp v37, v37, v37 row_ror:4 row_mask:0xf bank_mask:0xf
s_nop 0
v_add_f32_dpp v36, v36, v36 row_ror:8 row_mask:0xf bank_mask:0xf
v_add_f32_dpp v37, v37, v37 row_ror:8 row_mask:0xf bank_mask:0xf
v_mov_b32 v38, v36
v_mov_b32 v39, v37
s_nop 0
v_permlane16_swap_b32 v36, v38
v_permlane16_swap_b32 v37, v39
s_nop 0
v_add_f32 v36, v36, v38
v_add_f32 v37, v37, v39
v_mov_b32 v38, v36
v_mov_b32 v39, v37
s_nop 0
v_permlane32_swap_b32 v36, v38
v_permlane32_swap_b32 v37, v39
s_nop 0
v_add_f32 v36, v36, v38
v_add_f32 v37, v37, v39
s_mov_b64 exec, 0xf
ds_write_b64 v17, v[36:37] offset:7680
s_mov_b64 exec, 1
v_mov_b32 v9, 1
ds_add_u32 v1, v9 offset:3328
s_mov_b64 exec, -1
L_term_end:
s_endpgm
L_x:
s_sub_u32 s30, s30, 10
v_lshlrev_b32 v2, 4, v0
v_lshrrev_b32 v19, 3, v0
v_and_b32 v18, 7, v0
v_lshlrev_b32 v18, 4, v18
v_lshl_add_u32 v3, v19, 13, v18
s_mul_i32 s65, s64, 1179648
s_lshl_b32 s70, s31, 9
s_add_u32 s65, s65, s70
s_lshl_b32 s70, s33, 7
s_add_u32 s65, s65, s70
s_waitcnt lgkmcnt(0)
s_load_dwordx2 s[34:35], s[28:29], 0
s_cmp_lg_u32 s30, 0
s_cbranch_scc1 L_x_nold
s_mov_b32 s44, s10
s_and_b32 s45, s11, 0xffff
s_mov_b32 s46, 4718592
s_mov_b32 s47, 0x20000
s_add_u32 s65, s65, 1048576
s_mov_b32 s66, 32768
s_mov_b32 m0, s66
s_nop 0
buffer_load_dwordx4 v3, s[44:47], s65 offen nt lds
s_add_u32 s70, s65, 65536
s_mov_b32 s66, 33792
s_mov_b32 m0, s66
s_nop 0
buffer_load_dwordx4 v3, s[44:47], s70 offen nt lds
L_x_nold:
s_barrier
v_and_b32 v19, 15, v0
v_bfe_u32 v18, v19, 1, 1
v_lshlrev_b32 v18, 4, v18
v_mov_b32 v17, 0xffff
v_lshlrev_b32 v17, v18, v17
v_lshrrev_b32 v19, 2, v19
v_cmp_eq_u32 vcc, 0, v19
s_nop 1
v_cndmask_b32 v10, 0, v17, vcc
v_cmp_eq_u32 vcc, 1, v19
s_nop 1
v_cndmask_b32 v11, 0, v17, vcc
v_cmp_eq_u32 vcc, 2, v19
s_nop 1
v_cndmask_b32 v12, 0, v17, vcc
v_cmp_eq_u32 vcc, 3, v19
s_nop 1
v_cndmask_b32 v13, 0, v17, vcc
v_lshrrev_b32 v18, 4, v0
v_and_b32 v17, 1, v0
v_lshl_add_u32 v15, v18, 1, v17
v_lshlrev_b32 v15, 2, v15
v_and_b32 v19, 7, v0
v_lshlrev_b32 v14, 5, v19
v_lshrrev_b32 v18, 4, v0
v_lshl_add_u32 v14, v18, 3, v14
s_cmp_lg_u32 s30, 0
s_cbranch_scc1 L_x_q
s_waitcnt vmcnt(0)
s_mov_b64 exec, 1
v_mov_b32 v9, 1
ds_add_u32 v1, v9 offset:3284
s_mov_b64 exec, -1
s_branch L_x_h
L_x_q:
s_sub_u32 s71, s30, 1
s_mul_i32 s66, s71, 6144
s_add_u32 s66, s66, 16384
s_mul_i32 s67, s64, 576
s_mul_i32 s70, s71, 192
s_add_u32 s67, s67, s70
s_mov_b32 s81, 0
L_spin_13:
ds_read_b32 v9, v1 offset:3280
s_waitcnt lgkmcnt(0)
v_readfirstlane_b32 s80, v9
s_cmp_ge_u32 s80, 1
s_cbranch_scc1 L_spun_14
s_add_u32 s81, s81, 1
s_cmp_lt_u32 s81, 1048576
s_cbranch_scc1 L_spin_13
s_endpgm
L_spun_14:
s_mov_b32 s81, 0
L_spin_15:
ds_read_b32 v9, v1 offset:3284
s_waitcnt lgkmcnt(0)
v_readfirstlane_b32 s80, v9
s_cmp_ge_u32 s80, 9
s_cbranch_scc1 L_spun_16
s_add_u32 s81, s81, 1
s_cmp_lt_u32 s81, 1048576
s_cbranch_scc1 L_spin_15
s_endpgm
L_spun_16:
v_add_u32 v16, s66, v2
v_add_u32 v17, s67, v15
ds_read_b32 v68, v17 offset:0
ds_read_b32 v69, v17 offset:32
ds_read_b32 v70, v17 offset:64
ds_read_b32 v71, v17 offset:96
ds_read_b32 v72, v17 offset:128
ds_read_b32 v73, v17 offset:160
ds_read_b128 v[20:23], v16 offset:0
ds_read_b128 v[24:27], v16 offset:1024
ds_read_b128 v[28:31], v16 offset:2048
ds_read_b128 v[32:35], v16 offset:3072
ds_read_b128 v[36:39], v16 offset:4096
ds_read_b128 v[40:43], v16 offset:5120
s_waitcnt lgkmcnt(6)
v_and_b32 v44, v10, v68
v_and_b32 v45, v11, v68
v_and_b32 v46, v12, v68
v_and_b32 v47, v13, v68
v_and_b32 v48, v10, v69
v_and_b32 v49, v11, v69
v_and_b32 v50, v12, v69
v_and_b32 v51, v13, v69
v_and_b32 v52, v10, v70
v_and_b32 v53, v11, v70
v_and_b32 v54, v12, v70
v_and_b32 v55, v13, v70
v_and_b32 v56, v10, v71
v_and_b32 v57, v11, v71
v_and_b32 v58, v12, v71
v_and_b32 v59, v13, v71
v_and_b32 v60, v10, v72
v_and_b32 v61, v11, v72
v_and_b32 v62, v12, v72
v_and_b32 v63, v13, v72
v_and_b32 v64, v10, v73
v_and_b32 v65, v11, v73
v_and_b32 v66, v12, v73
v_and_b32 v67, v13, v73
s_waitcnt lgkmcnt(0)
v_mfma_f32_16x16x32_bf16 v[76:79], v[44:47], v[20:23], 0
v_mfma_f32_16x16x32_bf16 v[76:79], v[48:51], v[24:27], v[76:79]
v_mfma_f32_16x16x32_bf16 v[76:79], v[52:55], v[28:31], v[76:79]
v_mfma_f32_16x16x32_bf16 v[76:79], v[56:59], v[32:35], v[76:79]
v_mfma_f32_16x16x32_bf16 v[76:79], v[60:63], v[36:39], v[76:79]
v_mfma_f32_16x16x32_bf16 v[76:79], v[64:67], v[40:43], v[76:79]
s_lshl_b32 s71, s71, 8
v_add_u32 v17, s71, v14
s_nop 7
v_add_f32_dpp v80, v77, v76 row_ror:8 row_mask:0xf bank_mask:0xf
v_add_f32_dpp v81, v79, v78 row_ror:8 row_mask:0xf bank_mask:0xf
s_mov_b32 exec_lo, 0x00ff00ff
s_mov_b32 exec_hi, 0x00ff00ff
ds_write_b64 v17, v[80:81] offset:3584
s_mov_b64 exec, 1
v_mov_b32 v9, 1
ds_add_u32 v1, v9 offset:3296
s_mov_b64 exec, -1
L_x_h:
s_cmp_ge_u32 s2, 216
s_cbranch_scc1 L_x_qk
s_mul_i32 s66, s30, 6144
s_add_u32 s66, s66, 34816
s_mul_hi_u32 s67, s2, 59652324
s_mul_i32 s67, s67, 768
s_mul_i32 s70, s30, 192
s_add_u32 s67, s67, s70
s_mov_b32 s81, 0
L_spin_17:
ds_read_b32 v9, v1 offset:3280
s_waitcnt lgkmcnt(0)
v_readfirstlane_b32 s80, v9
s_cmp_ge_u32 s80, 1
s_cbranch_scc1 L_spun_18
s_add_u32 s81, s81, 1
s_cmp_lt_u32 s81, 1048576
s_cbranch_scc1 L_spin_17
s_endpgm
L_spun_18:
s_mov_b32 s81, 0
L_spin_19:
ds_read_b32 v9, v1 offset:3288
s_waitcnt lgkmcnt(0)
v_readfirstlane_b32 s80, v9
s_cmp_ge_u32 s80, 8
s_cbranch_scc1 L_spun_20
s_add_u32 s81, s81, 1
s_cmp_lt_u32 s81, 1048576
s_cbranch_scc1 L_spin_19
s_endpgm
L_spun_20:
s_mov_b32 s71, s30
v_add_u32 v16, s66, v2
v_add_u32 v17, s67, v15
ds_read_b32 v68, v17 offset:0
ds_read_b32 v69, v17 offset:32
ds_read_b32 v70, v17 offset:64
ds_read_b32 v71, v17 offset:96
ds_read_b32 v72, v17 offset:128
ds_read_b32 v73, v17 offset:160
ds_read_b128 v[20:23], v16 offset:0
ds_read_b128 v[24:27], v16 offset:1024
ds_read_b128 v[28:31], v16 offset:2048
ds_read_b128 v[32:35], v16 offset:3072
ds_read_b128 v[36:39], v16 offset:4096
ds_read_b128 v[40:43], v16 offset:5120
s_waitcnt lgkmcnt(6)
v_and_b32 v44, v10, v68
v_and_b32 v45, v11, v68
v_and_b32 v46, v12, v68
v_and_b32 v47, v13, v68
v_and_b32 v48, v10, v69
v_and_b32 v49, v11, v69
v_and_b32 v50, v12, v69
v_and_b32 v51, v13, v69
v_and_b32 v52, v10, v70
v_and_b32 v53, v11, v70
v_and_b32 v54, v12, v70
v_and_b32 v55, v13, v70
v_and_b32 v56, v10, v71
v_and_b32 v57, v11, v71
v_and_b32 v58, v12, v71
v_and_b32 v59, v13, v71
v_and_b32 v60, v10, v72
v_and_b32 v61, v11, v72
v_and_b32 v62, v12, v72
v_and_b32 v63, v13, v72
v_and_b32 v64, v10, v73
v_and_b32 v65, v11, v73
v_and_b32 v66, v12, v73
v_and_b32 v67, v13, v73
s_waitcnt lgkmcnt(0)
v_mfma_f32_16x16x32_bf16 v[76:79], v[44:47], v[20:23], 0
v_mfma_f32_16x16x32_bf16 v[76:79], v[48:51], v[24:27], v[76:79]
v_mfma_f32_16x16x32_bf16 v[76:79], v[52:55], v[28:31], v[76:79]
v_mfma_f32_16x16x32_bf16 v[76:79], v[56:59], v[32:35], v[76:79]
v_mfma_f32_16x16x32_bf16 v[76:79], v[60:63], v[36:39], v[76:79]
v_mfma_f32_16x16x32_bf16 v[76:79], v[64:67], v[40:43], v[76:79]
s_lshl_b32 s71, s71, 8
v_add_u32 v17, s71, v14
s_nop 7
v_add_f32_dpp v80, v77, v76 row_ror:8 row_mask:0xf bank_mask:0xf
v_add_f32_dpp v81, v79, v78 row_ror:8 row_mask:0xf bank_mask:0xf
s_mov_b32 exec_lo, 0x00ff00ff
s_mov_b32 exec_hi, 0x00ff00ff
ds_write_b64 v17, v[80:81] offset:4608
s_mov_b64 exec, 1
v_mov_b32 v9, 1
ds_add_u32 v1, v9 offset:3300
s_mov_b64 exec, -1
L_x_qk:
v_and_b32 v18, 15, v0
v_lshrrev_b32 v19, 4, v0
v_lshlrev_b32 v17, 4, v19
v_lshl_add_u32 v4, v18, 5, v17
v_add_u32 v4, 2304, v4
v_mov_b32 v5, 2816
v_and_b32 v3, 7, v18
v_cmp_eq_u32 vcc, 0, v3
s_nop 1
v_cndmask_b32 v3, v5, v4, vcc
v_subrev_u32 v4, 128, v4
v_and_b32 v17, 7, v18
v_cmp_eq_u32 vcc, 4, v17
s_nop 1
v_cndmask_b32 v4, v5, v4, vcc
s_lshl_b32 s71, s30, 14
s_add_u32 s71, s71, 59392
v_lshl_add_u32 v5, v18, 8, s71
v_add_u32 v17, 0, v19
v_xor_b32 v17, v17, v18
v_lshl_add_u32 v68, v17, 4, v5
v_add_u32 v17, 4, v19
v_xor_b32 v17, v17, v18
v_lshl_add_u32 v69, v17, 4, v5
v_add_u32 v17, 8, v19
v_xor_b32 v17, v17, v18
v_lshl_add_u32 v70, v17, 4, v5
v_add_u32 v17, 12, v19
v_xor_b32 v17, v17, v18
v_lshl_add_u32 v71, v17, 4, v5
v_lshrrev_b32 v7, 5, v0
v_lshlrev_b32 v6, 10, v7
v_lshlrev_b32 v7, 2, v7
v_and_b32 v17, 31, v0
v_lshl_add_u32 v6, v17, 2, v6
s_lshl_b32 s71, s30, 8
s_add_u32 s71, s71, 5632
v_add_u32 v6, s71, v6
v_mov_b32 v124, v68
v_mov_b32 v125, v69
v_mov_b32 v126, v70
v_mov_b32 v127, v71
s_mov_b32 s81, 0
L_spin_21:
ds_read_b32 v9, v1 offset:3292
s_waitcnt lgkmcnt(0)
v_readfirstlane_b32 s80, v9
s_cmp_ge_u32 s80, 8
s_cbranch_scc1 L_spun_22
s_add_u32 s81, s81, 1
s_cmp_lt_u32 s81, 1048576
s_cbranch_scc1 L_spin_21
s_endpgm
L_spun_22:
ds_read_b128 v[52:55], v124 offset:0
ds_read_b128 v[56:59], v125 offset:0
ds_read_b128 v[60:63], v126 offset:0
ds_read_b128 v[64:67], v127 offset:0
ds_read_b128 v[68:71], v124 offset:4096
ds_read_b128 v[72:75], v125 offset:4096
ds_read_b128 v[76:79], v126 offset:4096
ds_read_b128 v[80:83], v127 offset:4096
ds_read_b128 v[84:87], v124 offset:8192
ds_read_b128 v[88:91], v125 offset:8192
ds_read_b128 v[92:95], v126 offset:8192
ds_read_b128 v[96:99], v127 offset:8192
ds_read_b128 v[100:103], v124 offset:12288
ds_read_b128 v[104:107], v125 offset:12288
ds_read_b128 v[108:111], v126 offset:12288
ds_read_b128 v[112:115], v127 offset:12288
s_mov_b32 s81, 0
L_spin_23:
ds_read_b32 v9, v1 offset:3304
s_waitcnt lgkmcnt(0)
v_readfirstlane_b32 s80, v9
s_cmp_ge_u32 s80, 1
s_cbranch_scc1 L_spun_24
s_add_u32 s81, s81, 1
s_cmp_lt_u32 s81, 1048576
s_cbranch_scc1 L_spin_23
s_endpgm
L_spun_24:
s_add_u32 s34, s34, 1
s_addc_u32 s35, s35, 0
ds_read_b128 v[20:23], v3 offset:0
ds_read_b128 v[24:27], v3 offset:64
ds_read_b128 v[28:31], v3 offset:128
ds_read_b128 v[32:35], v3 offset:192
ds_read_b128 v[36:39], v4 offset:0
ds_read_b128 v[40:43], v4 offset:64
ds_read_b128 v[44:47], v4 offset:128
ds_read_b128 v[48:51], v4 offset:192
s_waitcnt lgkmcnt(0)
v_mfma_f32_16x16x32_bf16 v[116:119], v[20:23], v[52:55], 0
v_mfma_f32_16x16x32_bf16 v[116:119], v[24:27], v[56:59], v[116:119]
v_mfma_f32_16x16x32_bf16 v[116:119], v[28:31], v[60:63], v[116:119]
v_mfma_f32_16x16x32_bf16 v[116:119], v[32:35], v[64:67], v[116:119]
v_mfma_f32_16x16x32_bf16 v[116:119], v[36:39], v[68:71], v[116:119]
v_mfma_f32_16x16x32_bf16 v[116:119], v[40:43], v[72:75], v[116:119]
v_mfma_f32_16x16x32_bf16 v[116:119], v[44:47], v[76:79], v[116:119]
v_mfma_f32_16x16x32_bf16 v[116:119], v[48:51], v[80:83], v[116:119]
v_mfma_f32_16x16x32_bf16 v[120:123], v[20:23], v[84:87], 0
v_mfma_f32_16x16x32_bf16 v[120:123], v[24:27], v[88:91], v[120:123]
v_mfma_f32_16x16x32_bf16 v[120:123], v[28:31], v[92:95], v[120:123]
v_mfma_f32_16x16x32_bf16 v[120:123], v[32:35], v[96:99], v[120:123]
v_mfma_f32_16x16x32_bf16 v[120:123], v[36:39], v[100:103], v[120:123]
v_mfma_f32_16x16x32_bf16 v[120:123], v[40:43], v[104:107], v[120:123]
v_mfma_f32_16x16x32_bf16 v[120:123], v[44:47], v[108:111], v[120:123]
v_mfma_f32_16x16x32_bf16 v[120:123], v[48:51], v[112:115], v[120:123]
s_nop 7
v_cvt_pk_bf16_f32 v116, v116, v116
v_and_b32 v116, 0xffff0000, v116
v_mul_f32 v116, 0x3db504f3, v116
v_cvt_pk_bf16_f32 v116, v116, v116
v_and_b32 v116, 0xffff0000, v116
v_cvt_pk_bf16_f32 v120, v120, v120
v_and_b32 v120, 0xffff0000, v120
v_mul_f32 v120, 0x3db504f3, v120
v_cvt_pk_bf16_f32 v120, v120, v120
v_and_b32 v120, 0xffff0000, v120
v_max_f32 v117, v116, v120
s_nop 1
v_max_f32_dpp v117, v117, v117 row_ror:1 row_mask:0xf bank_mask:0xf
s_nop 1
v_max_f32_dpp v117, v117, v117 row_ror:2 row_mask:0xf bank_mask:0xf
s_nop 1
v_max_f32_dpp v117, v117, v117 row_ror:4 row_mask:0xf bank_mask:0xf
s_nop 1
v_max_f32_dpp v117, v117, v117 row_ror:8 row_mask:0xf bank_mask:0xf
v_mov_b32 v118, v117
s_nop 1
v_permlane16_swap_b32 v117, v118
s_nop 0
v_max_f32 v117, v117, v118
s_mov_b32 exec_lo, 1
s_mov_b32 exec_hi, 1
ds_max_f32 v7, v117 offset:3264
s_mov_b64 exec, 1
v_mov_b32 v9, 1
ds_add_u32 v1, v9 offset:3308
s_mov_b64 exec, -1
s_mov_b32 s81, 0
L_mspin_25:
ds_read_b32 v9, v1 offset:3308
ds_read_b32 v117, v7 offset:3264
s_waitcnt lgkmcnt(0)
v_readfirstlane_b32 s80, v9
s_cmp_ge_u32 s80, 4
s_cbranch_scc1 L_mdone_26
s_add_u32 s81, s81, 1
s_cmp_lt_u32 s81, 1048576
s_cbranch_scc1 L_mspin_25
s_endpgm
L_mdone_26:
v_sub_f32 v116, v116, v117
v_sub_f32 v120, v120, v117
v_mul_f32 v116, 0x3fb8aa3b, v116
v_mul_f32 v120, 0x3fb8aa3b, v120
v_exp_f32 v116, v116
v_exp_f32 v120, v120
s_nop 0
v_cvt_pk_bf16_f32 v118, v116, v116
v_cvt_pk_bf16_f32 v119, v120, v120
v_add_f32 v116, v116, v120
ds_write_b32 v6, v118
ds_write_b32 v6, v119 offset:128
s_mov_b64 exec, 1
v_mov_b32 v9, 1
ds_add_u32 v1, v9 offset:3336
s_mov_b64 exec, -1
s_nop 1
v_add_f32_dpp v116, v116, v116 row_ror:1 row_mask:0xf bank_mask:0xf
s_nop 1
v_add_f32_dpp v116, v116, v116 row_ror:2 row_mask:0xf bank_mask:0xf
s_nop 1
v_add_f32_dpp v116, v116, v116 row_ror:4 row_mask:0xf bank_mask:0xf
s_nop 1
v_add_f32_dpp v116, v116, v116 row_ror:8 row_mask:0xf bank_mask:0xf
v_mov_b32 v117, v116
s_nop 1
v_permlane16_swap_b32 v116, v117
s_nop 0
v_add_f32 v116, v116, v117
s_mov_b32 exec_lo, 1
s_mov_b32 exec_hi, 1
s_lshl_b32 s70, s30, 2
v_lshl_add_u32 v17, v7, 2, s70
ds_write_b32 v17, v116 offset:3392
s_mov_b64 exec, 1
v_mov_b32 v9, 1
ds_add_u32 v1, v9 offset:3312
s_mov_b64 exec, -1
s_cmp_eq_u32 s30, 0
s_cbranch_scc1 L_t8
L_x_end:
s_endpgm
L_t8:
s_mov_b32 s30, 8
v_lshrrev_b32 v19, 3, v0
v_and_b32 v18, 7, v0
v_lshlrev_b32 v18, 4, v18
v_mul_u32_u24 v5, 1152, v19
v_add_u32 v5, v5, v18
s_mov_b32 s52, s20
s_and_b32 s53, s21, 0xffff
s_mov_b32 s54, 0
s_mov_b32 s55, 0x20000
s_mov_b32 s56, s20
s_and_b32 s57, s21, 0xffff
s_mov_b32 s58, 0
s_mov_b32 s59, 0x20000
s_mov_b32 s60, s12
s_and_b32 s61, s13, 0xffff
s_mov_b32 s62, 4718592
s_mov_b32 s63, 0x20000
s_cmp_lt_u32 s2, 252
s_cselect_b32 s54, 5308416, 0
s_cmp_ge_u32 s2, 216
s_cselect_b32 s58, s54, 0
s_lshl_b32 s72, s2, 4
s_lshl_b32 s70, s2, 5
s_sub_u32 s70, s70, 3456
s_cmp_lt_u32 s2, 216
s_cselect_b32 s72, s72, s70
s_mul_i32 s72, s72, 1152
s_lshl_b32 s70, s30, 7
s_add_u32 s72, s72, s70
s_lshl_b32 s73, s31, 4
s_add_u32 s73, s73, s32
s_mul_i32 s73, s73, 18432
s_add_u32 s73, s73, s70
s_and_b32 s71, s2, 7
s_lshl_b32 s71, s71, 5
s_lshr_b32 s70, s2, 3
s_add_u32 s71, s71, s70
s_lshl_b32 s71, s71, 6
s_lshl_b32 s70, s30, 17
s_add_u32 s70, s70, s71
s_add_u32 s70, s70, 1048576
s_add_u32 s74, s28, s70
s_addc_u32 s75, s29, 0
v_and_b32 v19, 7, v0
v_lshlrev_b32 v14, 14, v19
v_lshrrev_b32 v18, 4, v0
v_lshl_add_u32 v14, v18, 4, v14
s_mov_b32 s81, 0
L_spin_27:
ds_read_b32 v9, v1 offset:3332
s_waitcnt lgkmcnt(0)
v_readfirstlane_b32 s80, v9
s_cmp_ge_u32 s80, 17
s_cbranch_scc1 L_spun_28
s_add_u32 s81, s81, 1
s_cmp_lt_u32 s81, 1048576
s_cbranch_scc1 L_spin_27
s_endpgm
L_spun_28:
s_add_u32 s70, s72, 0
buffer_load_dwordx4 v[20:23], v5, s[52:55], s70 offen nt
s_add_u32 s70, s72, 9216
buffer_load_dwordx4 v[24:27], v5, s[52:55], s70 offen nt
s_add_u32 s70, s73, 0
buffer_load_dwordx4 v[28:31], v5, s[60:63], s70 offen nt
s_add_u32 s70, s73, 9216
buffer_load_dwordx4 v[32:35], v5, s[60:63], s70 offen nt
s_branch L_term
L_c1:
s_setprio 3
v_lshlrev_b32 v2, 2, v0
s_waitcnt lgkmcnt(0)
s_mov_b32 s36, s4
s_and_b32 s37, s5, 0xffff
s_mov_b32 s38, 1152
s_mov_b32 s39, 0x20000
buffer_load_dword v10, v2, s[36:39], 0 offen offset:0
buffer_load_dword v11, v2, s[36:39], 0 offen offset:256
buffer_load_dword v12, v2, s[36:39], 0 offen offset:512
buffer_load_dword v13, v2, s[36:39], 0 offen offset:768
buffer_load_dword v14, v2, s[36:39], 0 offen offset:1024
s_load_dwordx2 s[34:35], s[28:29], 0
s_barrier
s_waitcnt vmcnt(0)
v_lshlrev_b32 v20, 16, v10
v_and_b32 v21, 0xffff0000, v10
v_lshlrev_b32 v22, 16, v11
v_and_b32 v23, 0xffff0000, v11
v_lshlrev_b32 v24, 16, v12
v_and_b32 v25, 0xffff0000, v12
v_lshlrev_b32 v26, 16, v13
v_and_b32 v27, 0xffff0000, v13
v_lshlrev_b32 v28, 16, v14
v_and_b32 v29, 0xffff0000, v14
v_add_f32 v30, v20, v21
v_add_f32 v31, v22, v23
v_add_f32 v42, v24, v25
v_add_f32 v43, v26, v27
v_add_f32 v44, v28, v29
v_add_f32 v30, v30, v31
v_add_f32 v42, v42, v43
v_add_f32 v30, v30, v44
v_add_f32 v30, v30, v42
s_nop 1
v_add_f32_dpp v30, v30, v30 row_ror:1 row_mask:0xf bank_mask:0xf
s_nop 1
v_add_f32_dpp v30, v30, v30 row_ror:2 row_mask:0xf bank_mask:0xf
s_nop 1
v_add_f32_dpp v30, v30, v30 row_ror:4 row_mask:0xf bank_mask:0xf
s_nop 1
v_add_f32_dpp v30, v30, v30 row_ror:8 row_mask:0xf bank_mask:0xf
v_mov_b32 v31, v30
s_nop 1
v_permlane16_swap_b32 v30, v31
s_nop 0
v_add_f32 v30, v30, v31
v_mov_b32 v31, v30
s_nop 1
v_permlane32_swap_b32 v30, v31
s_nop 0
v_add_f32 v30, v30, v31
v_mul_f32 v30, 0x3ae38e39, v30
v_cmp_gt_u32 vcc, 32, v0
v_sub_f32 v32, v20, v30
v_sub_f32 v33, v21, v30
v_sub_f32 v34, v22, v30
v_sub_f32 v35, v23, v30
v_sub_f32 v36, v24, v30
v_sub_f32 v37, v25, v30
v_sub_f32 v38, v26, v30
v_sub_f32 v39, v27, v30
v_sub_f32 v40, v28, v30
v_sub_f32 v41, v29, v30
v_cndmask_b32 v40, 0, v40, vcc
v_cndmask_b32 v41, 0, v41, vcc
v_mul_f32 v31, v32, v32
v_mul_f32 v42, v33, v33
v_fmac_f32 v31, v34, v34
v_fmac_f32 v42, v35, v35
v_fmac_f32 v31, v36, v36
v_fmac_f32 v42, v37, v37
v_fmac_f32 v31, v38, v38
v_fmac_f32 v42, v39, v39
v_fmac_f32 v31, v40, v40
v_fmac_f32 v42, v41, v41
v_add_f32 v31, v31, v42
s_nop 1
v_add_f32_dpp v31, v31, v31 row_ror:1 row_mask:0xf bank_mask:0xf
s_nop 1
v_add_f32_dpp v31, v31, v31 row_ror:2 row_mask:0xf bank_mask:0xf
s_nop 1
v_add_f32_dpp v31, v31, v31 row_ror:4 row_mask:0xf bank_mask:0xf
s_nop 1
v_add_f32_dpp v31, v31, v31 row_ror:8 row_mask:0xf bank_mask:0xf
v_mov_b32 v42, v31
s_nop 1
v_permlane16_swap_b32 v31, v42
s_nop 0
v_add_f32 v31, v31, v42
v_mov_b32 v42, v31
s_nop 1
v_permlane32_swap_b32 v31, v42
s_nop 0
v_add_f32 v31, v31, v42
v_mul_f32 v31, 0x3ae38e39, v31
v_cvt_pk_bf16_f32 v30, v30, v30
v_and_b32 v30, 0xffff0000, v30
v_cvt_pk_bf16_f32 v31, v31, v31
v_and_b32 v31, 0xffff0000, v31
v_add_f32 v31, 0x3727c5ac, v31
v_cvt_pk_bf16_f32 v31, v31, v31
v_and_b32 v31, 0xffff0000, v31
v_sqrt_f32 v31, v31
s_nop 0
v_cvt_pk_bf16_f32 v31, v31, v31
v_and_b32 v31, 0xffff0000, v31
v_rcp_f32 v31, v31
v_sub_f32 v32, v20, v30
v_sub_f32 v33, v21, v30
v_sub_f32 v34, v22, v30
v_sub_f32 v35, v23, v30
v_sub_f32 v36, v24, v30
v_sub_f32 v37, v25, v30
v_sub_f32 v38, v26, v30
v_sub_f32 v39, v27, v30
v_sub_f32 v40, v28, v30
v_sub_f32 v41, v29, v30
v_cvt_pk_bf16_f32 v32, v32, v32
v_cvt_pk_bf16_f32 v33, v33, v33
v_cvt_pk_bf16_f32 v34, v34, v34
v_cvt_pk_bf16_f32 v35, v35, v35
v_cvt_pk_bf16_f32 v36, v36, v36
v_cvt_pk_bf16_f32 v37, v37, v37
v_cvt_pk_bf16_f32 v38, v38, v38
v_cvt_pk_bf16_f32 v39, v39, v39
v_cvt_pk_bf16_f32 v40, v40, v40
v_cvt_pk_bf16_f32 v41, v41, v41
v_and_b32 v32, 0xffff0000, v32
v_and_b32 v33, 0xffff0000, v33
v_and_b32 v34, 0xffff0000, v34
v_and_b32 v35, 0xffff0000, v35
v_and_b32 v36, 0xffff0000, v36
v_and_b32 v37, 0xffff0000, v37
v_and_b32 v38, 0xffff0000, v38
v_and_b32 v39, 0xffff0000, v39
v_and_b32 v40, 0xffff0000, v40
v_and_b32 v41, 0xffff0000, v41
v_mul_f32 v32, v32, v31
v_mul_f32 v33, v33, v31
v_mul_f32 v34, v34, v31
v_mul_f32 v35, v35, v31
v_mul_f32 v36, v36, v31
v_mul_f32 v37, v37, v31
v_mul_f32 v38, v38, v31
v_mul_f32 v39, v39, v31
v_mul_f32 v40, v40, v31
v_mul_f32 v41, v41, v31
v_cvt_pk_bf16_f32 v32, v32, v32
v_cvt_pk_bf16_f32 v33, v33, v33
v_cvt_pk_bf16_f32 v34, v34, v34
v_cvt_pk_bf16_f32 v35, v35, v35
v_cvt_pk_bf16_f32 v36, v36, v36
v_cvt_pk_bf16_f32 v37, v37, v37
v_cvt_pk_bf16_f32 v38, v38, v38
v_cvt_pk_bf16_f32 v39, v39, v39
v_cvt_pk_bf16_f32 v40, v40, v40
v_cvt_pk_bf16_f32 v41, v41, v41
v_lshlrev_b32 v3, 3, v0
ds_write_b64 v3, v[32:33] offset:0
ds_write_b64 v3, v[34:35] offset:512
ds_write_b64 v3, v[36:37] offset:1024
ds_write_b64 v3, v[38:39] offset:1536
s_mov_b32 exec_hi, 0
ds_write_b64 v3, v[40:41] offset:2048
s_mov_b64 exec, -1
s_mov_b64 exec, 1
v_mov_b32 v19, 1
ds_add_u32 v1, v19 offset:3280
s_mov_b64 exec, -1
s_waitcnt lgkmcnt(0)
s_add_u32 s34, s34, 1
s_addc_u32 s35, s35, 0
s_lshl_b32 s70, s31, 13
s_add_u32 s70, s70, 4096
s_add_u32 s40, s28, s70
s_addc_u32 s41, s29, 0
s_lshl_b32 s70, s64, 11
s_lshl_b32 s71, s33, 9
s_add_u32 s70, s70, s71
v_lshlrev_b32 v4, 4, v0
v_add_u32 v5, s70, v4
v_mov_b32 v46, s34
v_mov_b32 v47, s35
s_getreg_b32 s79, hwreg(HW_REG_XCC_ID, 0, 4)
s_mul_i32 s70, s31, 7936
s_sub_u32 s78, 131072, s70
v_and_b32 v6, 15, v0
v_lshlrev_b32 v6, 4, v6
v_add_u32 v6, s78, v6
s_lshl_b32 s70, s32, 4
s_add_u32 s78, s78, s70
s_mov_b32 s81, 0
L_spin_29:
ds_read_b32 v19, v1 offset:3296
s_waitcnt lgkmcnt(0)
v_readfirstlane_b32 s80, v19
s_cmp_ge_u32 s80, 3
s_cbranch_scc1 L_spun_30
s_add_u32 s81, s81, 1
s_cmp_lt_u32 s81, 1048576
s_cbranch_scc1 L_spin_29
s_endpgm
L_spun_30:
ds_read_b64 v[48:49], v3 offset:3584
ds_read_b64 v[50:51], v3 offset:3840
ds_read_b64 v[52:53], v3 offset:4096
s_waitcnt lgkmcnt(0)
v_add_f32 v44, v48, v50
v_add_f32 v45, v49, v51
v_add_f32 v44, v44, v52
v_add_f32 v45, v45, v53
s_mov_b32 exec_lo, 0
s_mov_b32 exec_hi, 1
v_mov_b32 v44, s79
v_mov_b32 v45, 0
v_mov_b32 v5, s78
s_mov_b32 exec_lo, -1
s_add_u32 s42, s40, 4194304
s_addc_u32 s43, s41, 0
global_store_dwordx4 v5, v[44:47], s[42:43]
global_store_dwordx4 v5, v[44:47], s[40:41] sc1
s_mov_b64 exec, -1
v_add_u32 v5, 4096, v4
s_mov_b32 s81, 0
L_spin_31:
ds_read_b32 v19, v1 offset:3332
s_waitcnt lgkmcnt(0)
v_readfirstlane_b32 s80, v19
s_cmp_ge_u32 s80, 9
s_cbranch_scc1 L_spun_32
s_add_u32 s81, s81, 1
s_cmp_lt_u32 s81, 1048576
s_cbranch_scc1 L_spin_31
s_endpgm
L_spun_32:
s_mov_b32 s48, s42
s_mov_b32 s49, s43
s_mov_b32 s81, 0
L_x1_33:
global_load_dwordx4 v[48:51], v4, s[48:49] offset:0 sc1
global_load_dwordx4 v[52:55], v4, s[48:49] offset:1024 sc1
global_load_dwordx4 v[56:59], v4, s[48:49] offset:2048 sc1
global_load_dwordx4 v[60:63], v4, s[48:49] offset:3072 sc1
global_load_dwordx4 v[64:67], v5, s[48:49] offset:0 sc1
global_load_dwordx4 v[68:71], v5, s[48:49] offset:1024 sc1
global_load_dwordx4 v[72:75], v5, s[48:49] offset:2048 sc1
global_load_dwordx4 v[76:79], v5, s[48:49] offset:3072 sc1
global_load_dwordx4 v[80:83], v6, s[48:49] sc1
s_waitcnt vmcnt(0)
v_cmp_ne_u64 s[76:77], s[34:35], v[50:51]
v_cmp_ne_u64 vcc, s[34:35], v[54:55]
s_or_b64 s[76:77], s[76:77], vcc
v_cmp_ne_u64 vcc, s[34:35], v[58:59]
s_or_b64 s[76:77], s[76:77], vcc
v_cmp_ne_u64 vcc, s[34:35], v[62:63]
s_or_b64 s[76:77], s[76:77], vcc
v_cmp_ne_u64 vcc, s[34:35], v[66:67]
s_or_b64 s[76:77], s[76:77], vcc
v_cmp_ne_u64 vcc, s[34:35], v[70:71]
s_or_b64 s[76:77], s[76:77], vcc
v_cmp_ne_u64 vcc, s[34:35], v[74:75]
s_or_b64 s[76:77], s[76:77], vcc
v_cmp_ne_u64 vcc, s[34:35], v[78:79]
s_or_b64 s[76:77], s[76:77], vcc
v_cmp_ne_u64 vcc, s[34:35], v[82:83]
s_or_b64 s[76:77], s[76:77], vcc
s_cmp_eq_u64 s[76:77], 0
s_cbranch_scc1 L_x1ok_34
ds_read_b32 v19, v1 offset:3332
s_waitcnt lgkmcnt(0)
v_readfirstlane_b32 s80, v19
s_cmp_lt_u32 s80, 12
s_cbranch_scc1 L_x1nofb_35
s_mov_b32 s48, s40
s_mov_b32 s49, s41
L_x1nofb_35:
s_add_u32 s81, s81, 1
s_cmp_lt_u32 s81, 65536
s_cbranch_scc1 L_x1_33
s_endpgm
L_x1ok_34:
v_readfirstlane_b32 s70, v80
s_nop 1
v_cmp_ne_u32 vcc, s70, v80
s_cmp_eq_u64 vcc, 0
s_cselect_b32 s79, 1, 0
v_add_f32 v48, v48, v56
v_add_f32 v64, v64, v72
v_add_f32 v48, v48, v64
v_add_f32 v49, v49, v57
v_add_f32 v65, v65, v73
v_add_f32 v49, v49, v65
v_add_f32 v52, v52, v60
v_add_f32 v68, v68, v76
v_add_f32 v52, v52, v68
v_add_f32 v53, v53, v61
v_add_f32 v69, v69, v77
v_add_f32 v53, v53, v69
v_cvt_pk_bf16_f32 v48, v48, v49
v_cvt_pk_bf16_f32 v52, v52, v53
ds_write_b32 v2, v48 offset:2304
ds_write_b32 v2, v52 offset:2560
s_mov_b64 exec, 1
v_mov_b32 v19, 1
ds_add_u32 v1, v19 offset:3304
s_mov_b64 exec, -1
s_lshl_b32 s70, s31, 16
s_add_u32 s70, s70, 2621440
s_add_u32 s44, s28, s70
s_addc_u32 s45, s29, 0
v_lshrrev_b32 v7, 5, v0
v_lshlrev_b32 v7, 15, v7
v_bfe_u32 v6, v0, 1, 3
v_lshl_add_u32 v7, v6, 12, v7
v_and_b32 v6, 1, v0
v_lshl_add_u32 v7, v6, 6, v7
v_bfe_u32 v6, v0, 4, 1
v_lshl_add_u32 v7, v6, 5, v7
s_lshl_b32 s70, s32, 7
v_add_u32 v7, s70, v7
v_and_b32 v6, 15, v0
v_lshlrev_b32 v9, 12, v6
s_lshl_b32 s70, s32, 4
s_add_u32 s70, s70, 2048
v_add_u32 v9, s70, v9
v_lshrrev_b32 v6, 3, v6
v_lshlrev_b32 v10, 2, v6
v_lshlrev_b32 v11, 4, v6
v_mov_b32 v50, s34
v_mov_b32 v51, s35
v_mov_b32 v54, s34
v_mov_b32 v55, s35
v_mov_b32 v58, s34
v_mov_b32 v59, s35
s_lshl_b32 s70, s32, 12
s_add_u32 s46, s44, s70
s_addc_u32 s47, s45, 0
v_lshrrev_b32 v8, 3, v0
v_lshlrev_b32 v8, 4, v8
v_add_u32 v8, 2048, v8
s_mov_b32 s81, 0
L_spin_36:
ds_read_b32 v19, v1 offset:3312
s_waitcnt lgkmcnt(0)
v_readfirstlane_b32 s80, v19
s_cmp_ge_u32 s80, 4
s_cbranch_scc1 L_spun_37
s_add_u32 s81, s81, 1
s_cmp_lt_u32 s81, 1048576
s_cbranch_scc1 L_spin_36
s_endpgm
L_spun_37:
ds_read_b32 v56, v10 offset:3264
ds_read_b128 v[60:63], v11 offset:3392
s_waitcnt lgkmcnt(0)
v_add_f32 v60, v60, v61
v_add_f32 v62, v62, v63
v_add_f32 v57, v60, v62
s_mov_b32 s81, 0
L_spinw_38:
ds_read_b32 v19, v1 offset:3316
ds_read_b128 v[76:79], v4 offset:8192
ds_read_b128 v[80:83], v4 offset:9216
ds_read_b128 v[84:87], v4 offset:10240
ds_read_b128 v[88:91], v4 offset:11264
ds_read_b128 v[92:95], v4 offset:12288
ds_read_b128 v[96:99], v4 offset:13312
ds_read_b128 v[100:103], v4 offset:14336
ds_read_b128 v[104:107], v4 offset:15360
s_waitcnt lgkmcnt(0)
v_readfirstlane_b32 s80, v19
s_cmp_ge_u32 s80, 8
s_cbranch_scc1 L_spunw_39
s_add_u32 s81, s81, 1
s_cmp_lt_u32 s81, 1048576
s_cbranch_scc1 L_spinw_38
s_endpgm
L_spunw_39:
v_pk_add_f32 v[76:77], v[76:77], v[80:81]
v_pk_add_f32 v[78:79], v[78:79], v[82:83]
v_pk_add_f32 v[84:85], v[84:85], v[88:89]
v_pk_add_f32 v[86:87], v[86:87], v[90:91]
v_pk_add_f32 v[92:93], v[92:93], v[96:97]
v_pk_add_f32 v[94:95], v[94:95], v[98:99]
v_pk_add_f32 v[100:101], v[100:101], v[104:105]
v_pk_add_f32 v[102:103], v[102:103], v[106:107]
v_pk_add_f32 v[76:77], v[76:77], v[84:85]
v_pk_add_f32 v[78:79], v[78:79], v[86:87]
v_pk_add_f32 v[92:93], v[92:93], v[100:101]
v_pk_add_f32 v[94:95], v[94:95], v[102:103]
v_pk_add_f32 v[48:49], v[76:77], v[92:93]
v_pk_add_f32 v[52:53], v[78:79], v[94:95]
s_cmp_eq_u32 s79, 0
s_cbranch_scc1 L_x2slow_40
global_store_dwordx4 v7, v[48:51], s[44:45]
global_store_dwordx4 v7, v[52:55], s[44:45] offset:16
s_mov_b64 exec, 0xffff
global_store_dwordx4 v9, v[56:59], s[44:45]
s_mov_b64 exec, -1
s_branch L_x2pub_41
L_x2slow_40:
global_store_dwordx4 v7, v[48:51], s[44:45] sc1
global_store_dwordx4 v7, v[52:55], s[44:45] offset:16 sc1
s_mov_b64 exec, 0xffff
global_store_dwordx4 v9, v[56:59], s[44:45] sc1
s_mov_b64 exec, -1
s_mov_b32 s81, 0
L_spin_42:
ds_read_b32 v19, v1 offset:3340
s_waitcnt lgkmcnt(0)
v_readfirstlane_b32 s80, v19
s_cmp_ge_u32 s80, 1
s_cbranch_scc1 L_spun_43
s_add_u32 s81, s81, 1
s_cmp_lt_u32 s81, 1048576
s_cbranch_scc1 L_spin_42
s_endpgm
L_spun_43:
L_x2pub_41:
s_mov_b32 s81, 0
global_load_dwordx4 v[60:63], v4, s[46:47] sc1
global_load_dwordx4 v[64:67], v4, s[46:47] offset:1024 sc1
global_load_dwordx4 v[68:71], v8, s[46:47] sc1
global_load_dwordx4 v[72:75], v8, s[46:47] offset:128 sc1
L_x2loop_44:
global_load_dwordx4 v[76:79], v4, s[46:47] sc1
global_load_dwordx4 v[80:83], v4, s[46:47] offset:1024 sc1
global_load_dwordx4 v[84:87], v8, s[46:47] sc1
global_load_dwordx4 v[88:91], v8, s[46:47] offset:128 sc1
s_waitcnt vmcnt(4)
v_cmp_ne_u64 s[76:77], s[34:35], v[62:63]
v_cmp_ne_u64 vcc, s[34:35], v[66:67]
s_or_b64 s[76:77], s[76:77], vcc
v_cmp_ne_u64 vcc, s[34:35], v[70:71]
s_or_b64 s[76:77], s[76:77], vcc
v_cmp_ne_u64 vcc, s[34:35], v[74:75]
s_or_b64 s[76:77], s[76:77], vcc
s_cmp_eq_u64 s[76:77], 0
s_cbranch_scc1 L_x2okA_45
global_load_dwordx4 v[60:63], v4, s[46:47] sc1
global_load_dwordx4 v[64:67], v4, s[46:47] offset:1024 sc1
global_load_dwordx4 v[68:71], v8, s[46:47] sc1
global_load_dwordx4 v[72:75], v8, s[46:47] offset:128 sc1
s_waitcnt vmcnt(4)
v_cmp_ne_u64 s[76:77], s[34:35], v[78:79]
v_cmp_ne_u64 vcc, s[34:35], v[82:83]
s_or_b64 s[76:77], s[76:77], vcc
v_cmp_ne_u64 vcc, s[34:35], v[86:87]
s_or_b64 s[76:77], s[76:77], vcc
v_cmp_ne_u64 vcc, s[34:35], v[90:91]
s_or_b64 s[76:77], s[76:77], vcc
s_cmp_eq_u64 s[76:77], 0
s_cbranch_scc1 L_x2okB_46
s_add_u32 s81, s81, 1
s_cmp_lt_u32 s81, 65536
s_cbranch_scc1 L_x2loop_44
s_endpgm
L_x2okA_45:
v_max_f32 v56, v68, v72
s_nop 1
v_max_f32_dpp v56, v56, v56 row_ror:8 row_mask:0xf bank_mask:0xf
v_mov_b32 v57, v56
s_nop 1
v_permlane16_swap_b32 v56, v57
s_nop 0
v_max_f32 v56, v56, v57
v_mov_b32 v57, v56
s_nop 1
v_permlane32_swap_b32 v56, v57
s_nop 0
v_max_f32 v56, v56, v57
v_sub_f32 v68, v68, v56
v_sub_f32 v72, v72, v56
v_mul_f32 v68, 0x3fb8aa3b, v68
v_mul_f32 v72, 0x3fb8aa3b, v72
v_exp_f32 v68, v68
v_exp_f32 v72, v72
s_nop 0
v_mul_f32 v60, v60, v68
v_mul_f32 v61, v61, v68
v_mul_f32 v62, v69, v68
v_fmac_f32 v60, v64, v72
v_fmac_f32 v61, v65, v72
v_fmac_f32 v62, v73, v72
s_nop 0
v_add_f32_dpp v60, v60, v60 row_ror:8 row_mask:0xf bank_mask:0xf
v_add_f32_dpp v61, v61, v61 row_ror:8 row_mask:0xf bank_mask:0xf
v_add_f32_dpp v62, v62, v62 row_ror:8 row_mask:0xf bank_mask:0xf
v_mov_b32 v56, v60
v_mov_b32 v57, v61
v_mov_b32 v58, v62
v_permlane16_swap_b32 v60, v56
v_permlane16_swap_b32 v61, v57
v_permlane16_swap_b32 v62, v58
v_add_f32 v60, v60, v56
v_add_f32 v61, v61, v57
v_add_f32 v62, v62, v58
v_mov_b32 v56, v60
v_mov_b32 v57, v61
v_mov_b32 v58, v62
v_permlane32_swap_b32 v60, v56
v_permlane32_swap_b32 v61, v57
v_permlane32_swap_b32 v62, v58
v_add_f32 v60, v60, v56
v_add_f32 v61, v61, v57
v_add_f32 v62, v62, v58
v_rcp_f32 v62, v62
s_nop 0
v_mul_f32 v60, v60, v62
v_mul_f32 v61, v61, v62
v_cvt_pk_bf16_f32 v60, v60, v60
v_cvt_pk_bf16_f32 v61, v61, v61
s_mov_b64 exec, 0xff
ds_write_b64 v3, v[60:61] offset:3200
s_mov_b64 exec, -1
s_branch L_o_done
L_x2okB_46:
v_max_f32 v56, v84, v88
s_nop 1
v_max_f32_dpp v56, v56, v56 row_ror:8 row_mask:0xf bank_mask:0xf
v_mov_b32 v57, v56
s_nop 1
v_permlane16_swap_b32 v56, v57
s_nop 0
v_max_f32 v56, v56, v57
v_mov_b32 v57, v56
s_nop 1
v_permlane32_swap_b32 v56, v57
s_nop 0
v_max_f32 v56, v56, v57
v_sub_f32 v84, v84, v56
v_sub_f32 v88, v88, v56
v_mul_f32 v84, 0x3fb8aa3b, v84
v_mul_f32 v88, 0x3fb8aa3b, v88
v_exp_f32 v84, v84
v_exp_f32 v88, v88
s_nop 0
v_mul_f32 v76, v76, v84
v_mul_f32 v77, v77, v84
v_mul_f32 v78, v85, v84
v_fmac_f32 v76, v80, v88
v_fmac_f32 v77, v81, v88
v_fmac_f32 v78, v89, v88
s_nop 0
v_add_f32_dpp v76, v76, v76 row_ror:8 row_mask:0xf bank_mask:0xf
v_add_f32_dpp v77, v77, v77 row_ror:8 row_mask:0xf bank_mask:0xf
v_add_f32_dpp v78, v78, v78 row_ror:8 row_mask:0xf bank_mask:0xf
v_mov_b32 v56, v76
v_mov_b32 v57, v77
v_mov_b32 v58, v78
v_permlane16_swap_b32 v76, v56
v_permlane16_swap_b32 v77, v57
v_permlane16_swap_b32 v78, v58
v_add_f32 v76, v76, v56
v_add_f32 v77, v77, v57
v_add_f32 v78, v78, v58
v_mov_b32 v56, v76
v_mov_b32 v57, v77
v_mov_b32 v58, v78
v_permlane32_swap_b32 v76, v56
v_permlane32_swap_b32 v77, v57
v_permlane32_swap_b32 v78, v58
v_add_f32 v76, v76, v56
v_add_f32 v77, v77, v57
v_add_f32 v78, v78, v58
v_rcp_f32 v78, v78
s_nop 0
v_mul_f32 v76, v76, v78
v_mul_f32 v77, v77, v78
v_cvt_pk_bf16_f32 v76, v76, v76
v_cvt_pk_bf16_f32 v77, v77, v77
s_mov_b64 exec, 0xff
ds_write_b64 v3, v[76:77] offset:3200
s_mov_b64 exec, -1
L_o_done:
s_mov_b64 exec, 1
v_mov_b32 v19, 1
ds_add_u32 v1, v19 offset:3324
s_mov_b64 exec, -1
s_endpgm
L_c2:
s_setprio 2
v_lshlrev_b32 v4, 4, v0
v_mov_b32 v8, 0
v_mov_b32 v9, 0
v_mov_b32 v10, 0
v_mov_b32 v11, 0
s_mov_b32 exec_hi, 0xffff
ds_write_b128 v4, v[8:11] offset:2816
s_mov_b64 exec, -1
v_mov_b32 v8, 0xff800000
v_mov_b32 v9, 0xff800000
s_mov_b64 exec, 1
ds_write_b64 v1, v[8:9] offset:3264
s_mov_b64 exec, -1
s_waitcnt lgkmcnt(0)
s_load_dwordx2 s[34:35], s[28:29], 0
s_barrier
s_lshl_b32 s72, s2, 4
s_lshl_b32 s70, s2, 5
s_sub_u32 s70, s70, 3456
s_cmp_lt_u32 s2, 216
s_cselect_b32 s72, s72, s70
s_cselect_b32 s73, 7, 15
v_and_b32 v5, s73, v0
s_mov_b32 s36, s18
s_and_b32 s37, s19, 0xffff
s_mov_b32 s38, 9216
s_mov_b32 s39, 0x20000
s_lshl_b32 s70, s72, 1
v_lshl_add_u32 v6, v5, 2, s70
buffer_load_dword v12, v6, s[36:39], 0 offen
s_mov_b32 s40, s4
s_and_b32 s41, s5, 0xffff
s_mov_b32 s42, 1152
s_mov_b32 s43, 0x20000
s_mov_b32 s44, s22
s_and_b32 s45, s23, 0xffff
s_mov_b32 s46, 1152
s_mov_b32 s47, 0x20000
v_and_b32 v7, 3, v0
v_lshlrev_b32 v7, 2, v7
s_lshl_b32 s70, s2, 4
v_add_u32 v7, s70, v7
buffer_load_dword v13, v7, s[40:43], 0 offen
buffer_load_dword v14, v7, s[44:47], 0 offen
v_lshlrev_b32 v3, 3, v0
s_waitcnt lgkmcnt(0)
s_add_u32 s34, s34, 1
s_addc_u32 s35, s35, 0
v_mov_b32 v46, s34
v_mov_b32 v47, s35
s_add_u32 s48, s28, 139264
s_addc_u32 s49, s29, 0
s_cmp_ge_u32 s2, 216
s_cbranch_scc1 L_c2_nopub
s_mul_hi_u32 s66, s2, 59652324
s_mul_i32 s70, s66, 72
s_sub_u32 s70, s2, s70
s_mul_i32 s70, s70, 1536
s_lshl_b32 s71, s66, 9
s_add_u32 s70, s70, s71
v_add_u32 v8, s70, v4
s_mov_b32 s81, 0
L_spin_47:
ds_read_b32 v15, v1 offset:3300
s_waitcnt lgkmcnt(0)
v_readfirstlane_b32 s80, v15
s_cmp_ge_u32 s80, 4
s_cbranch_scc1 L_spun_48
s_add_u32 s81, s81, 1
s_cmp_lt_u32 s81, 1048576
s_cbranch_scc1 L_spin_47
s_endpgm
L_spun_48:
ds_read_b64 v[48:49], v3 offset:4608
ds_read_b64 v[50:51], v3 offset:4864
ds_read_b64 v[52:53], v3 offset:5120
ds_read_b64 v[54:55], v3 offset:5376
s_waitcnt lgkmcnt(0)
v_add_f32 v48, v48, v50
v_add_f32 v49, v49, v51
v_add_f32 v52, v52, v54
v_add_f32 v53, v53, v55
v_add_f32 v48, v48, v52
v_add_f32 v49, v49, v53
v_mov_b32 v44, v48
v_mov_b32 v45, v49
s_mov_b32 exec_hi, 0
global_store_dwordx4 v8, v[44:47], s[48:49] sc1
s_mov_b64 exec, -1
L_c2_nopub:
s_cmp_ge_u32 s2, 252
s_cbranch_scc1 L_c2_hdone
s_lshr_b32 s70, s72, 6
s_mul_i32 s70, s70, 1536
s_and_b32 s71, s72, 63
s_lshl_b32 s71, s71, 3
s_add_u32 s70, s70, s71
v_lshl_add_u32 v8, v5, 4, s70
s_add_u32 s50, s48, s70
s_addc_u32 s51, s49, 0
s_mov_b32 s81, 0
L_spin_49:
ds_read_b32 v15, v1 offset:3332
s_waitcnt lgkmcnt(0)
v_readfirstlane_b32 s80, v15
s_cmp_ge_u32 s80, 14
s_cbranch_scc1 L_spun_50
s_add_u32 s81, s81, 1
s_cmp_lt_u32 s81, 1048576
s_cbranch_scc1 L_spin_49
s_endpgm
L_spun_50:
s_mov_b32 s81, 0
L_xh_51:
global_load_dwordx4 v[16:19], v8, s[48:49] offset:0 sc1
global_load_dwordx4 v[20:23], v8, s[48:49] offset:512 sc1
global_load_dwordx4 v[24:27], v8, s[48:49] offset:1024 sc1
s_waitcnt vmcnt(0)
v_cmp_ne_u64 s[76:77], s[34:35], v[18:19]
v_cmp_ne_u64 vcc, s[34:35], v[22:23]
s_or_b64 s[76:77], s[76:77], vcc
v_cmp_ne_u64 vcc, s[34:35], v[26:27]
s_or_b64 s[76:77], s[76:77], vcc
s_cmp_eq_u64 s[76:77], 0
s_cbranch_scc1 L_gok_52
s_add_u32 s81, s81, 1
s_cmp_lt_u32 s81, 65536
s_cbranch_scc1 L_xh_51
s_endpgm
L_gok_52:
v_add_f32 v16, v16, v20
v_add_f32 v16, v16, v24
v_cvt_pk_bf16_f32 v16, v16, v16
v_and_b32 v16, 0xffff0000, v16
v_add_f32 v17, v17, v21
v_add_f32 v17, v17, v25
v_cvt_pk_bf16_f32 v17, v17, v17
v_and_b32 v17, 0xffff0000, v17
v_lshlrev_b32 v18, 16, v12
v_and_b32 v19, 0xffff0000, v12
v_add_f32 v16, v16, v18
v_cvt_pk_bf16_f32 v16, v16, v16
v_and_b32 v16, 0xffff0000, v16
v_cmp_gt_f32 vcc, v16, 0
s_nop 1
v_cndmask_b32 v16, 0, v16, vcc
v_mul_f32 v16, v16, v16
v_cvt_pk_bf16_f32 v16, v16, v16
v_add_f32 v17, v17, v19
v_cvt_pk_bf16_f32 v17, v17, v17
v_and_b32 v17, 0xffff0000, v17
v_cmp_gt_f32 vcc, v17, 0
s_nop 1
v_cndmask_b32 v17, 0, v17, vcc
v_mul_f32 v17, v17, v17
v_cvt_pk_bf16_f32 v17, v17, v17
v_lshlrev_b32 v8, 3, v5
s_mov_b64 exec, 0xffff
ds_write_b64 v8, v[16:17] offset:3072
s_mov_b64 exec, -1
L_c2_hdone:
s_mov_b64 exec, 1
v_mov_b32 v15, 1
ds_add_u32 v1, v15 offset:3320
s_mov_b64 exec, -1
s_cmp_ge_u32 s2, 72
s_cbranch_scc1 L_c2_end
s_lshl_b32 s70, s2, 14
s_add_u32 s70, s70, 1048576
s_add_u32 s50, s28, s70
s_addc_u32 s51, s29, 0
v_add_u32 v5, 4096, v4
v_add_u32 v6, 8192, v4
v_add_u32 v8, 12288, v4
s_waitcnt vmcnt(0)
v_lshlrev_b32 v16, 16, v13
v_and_b32 v17, 0xffff0000, v13
v_lshlrev_b32 v18, 16, v14
v_and_b32 v19, 0xffff0000, v14
v_add_f32 v16, v16, v18
v_add_f32 v17, v17, v19
s_mov_b32 s52, s24
s_and_b32 s53, s25, 0xffff
s_mov_b32 s54, 1152
s_mov_b32 s55, 0x20000
v_and_b32 v5, 3, v0
v_lshlrev_b32 v5, 6, v5
s_mov_b32 s81, 0
L_spinw_53:
ds_read_b32 v15, v1 offset:3328
ds_read_b128 v[20:23], v5 offset:7680
ds_read_b128 v[24:27], v5 offset:7696
ds_read_b128 v[28:31], v5 offset:7712
ds_read_b128 v[32:35], v5 offset:7728
s_waitcnt lgkmcnt(0)
v_readfirstlane_b32 s80, v15
s_cmp_ge_u32 s80, 8
s_cbranch_scc1 L_spunw_54
s_add_u32 s81, s81, 1
s_cmp_lt_u32 s81, 1048576
s_cbranch_scc1 L_spinw_53
s_endpgm
L_spunw_54:
v_add_f32 v20, v20, v22
v_add_f32 v21, v21, v23
v_add_f32 v24, v24, v26
v_add_f32 v25, v25, v27
v_add_f32 v28, v28, v30
v_add_f32 v29, v29, v31
v_add_f32 v32, v32, v34
v_add_f32 v33, v33, v35
v_add_f32 v20, v20, v24
v_add_f32 v21, v21, v25
v_add_f32 v28, v28, v32
v_add_f32 v29, v29, v33
v_add_f32 v20, v20, v28
v_add_f32 v21, v21, v29
v_add_f32 v20, v20, v16
v_add_f32 v21, v21, v17
v_cvt_pk_bf16_f32 v20, v20, v21
s_mov_b64 exec, 0xf
buffer_store_dword v20, v7, s[52:55], 0 offen
s_cmp_lg_u32 s2, 0
s_cbranch_scc1 L_c2_noep
s_mov_b64 exec, 1
global_store_dwordx2 v1, v[46:47], s[28:29] sc1
L_c2_noep:
L_c2_end:
s_endpgm
L_end:
s_endpgm
.section .rodata,"a"
.p2align 6
.amdhsa_kernel parallel_sum__sliding_block_cached__dense_activation_squared_relu__decode_kernel
  .amdhsa_next_free_vgpr 128
  .amdhsa_next_free_sgpr 102
  .amdhsa_accum_offset 128
  .amdhsa_group_segment_fixed_size 0
  .amdhsa_kernarg_size 104
  .amdhsa_user_sgpr_count 2
  .amdhsa_user_sgpr_kernarg_segment_ptr 1
  .amdhsa_system_sgpr_workgroup_id_x 1
  .amdhsa_float_denorm_mode_32 3
.end_amdhsa_kernel
.text
```
